```python
import torch

def _softmax(x, axis=-1):
    return torch.softmax(x, dim=axis)
def _gelu(x):
    return torch.nn.functional.gelu(x, approximate="tanh")
def _silu(x):
    return torch.nn.functional.silu(x)
def _sigmoid(x):
    return torch.sigmoid(x)
def _layernorm(x, axis=-1, eps=1e-5):
    m = x.mean(dim=axis, keepdim=True)
    v = x.var(dim=axis, keepdim=True, unbiased=False)
    return (x - m) / torch.sqrt(v + eps)
def _scatter_add(tgt, idx, src, axis=0):
    return tgt.clone().index_add_(axis, idx, src)
def _segment_sum(src, seg, n):
    out = torch.zeros((n,) + src.shape[1:], dtype=src.dtype)
    return out.index_add_(0, seg, src)
def _pad(x, pw):
    flat = tuple(v for pair in reversed(pw) for v in pair)
    return torch.nn.functional.pad(x, flat)

kernel_name = 'standalone__batchnorm__prompt'

def setup_inputs():

    _w = (lambda a: (lambda t: t.to(torch.bfloat16) if t.is_floating_point() else t)(torch.as_tensor(a)))
    B, S, C = 1, 2048, 640
    K = 3
    return {
        "x": _w((lambda *s: torch.randn(*s, dtype=torch.bfloat16) * 0.05)(B, S, C)),
        "w": _w((lambda *s: torch.randn(*s, dtype=torch.bfloat16) * 0.05)(K, C, C) * (1.0 / (K * C) ** 0.5)),
        "mean": _w((lambda *s: torch.randn(*s, dtype=torch.bfloat16) * 0.05)(C) * 0.1),
        "var": _w(torch.abs((lambda *s: torch.randn(*s, dtype=torch.bfloat16) * 0.05)(C)) + 0.5),
        "g": _w((lambda *s: torch.randn(*s, dtype=torch.bfloat16) * 0.05)(C) + 1.0),
        "b": _w((lambda *s: torch.randn(*s, dtype=torch.bfloat16) * 0.05)(C) * 0.1),
    }

def reference(x, w, mean, var, g, b):
    K = 3
    P = K // 2
    S = x.shape[1]
    xp = _pad(x, ((0, 0), (P, P), (0, 0)))
    y = sum(torch.einsum('bsc,cd->bsd', xp[:, k:k + S, :], w[k]) for k in range(K))
    inv_std = 1.0 / torch.sqrt(var + 1e-5)
    y = (y - mean) * (g * inv_std) + b
    return _silu(y)
```

```asm
; @launch grid=(254,1,1) block=(512,1,1) lds=159744
.amdgcn_target "amdgcn-amd-amdhsa--gfx950"
.text
.globl standalone__batchnorm__prompt_kernel
.p2align 12
.fill 832, 4, 0xbf800000
.p2align 8
.type standalone__batchnorm__prompt_kernel,@function
standalone__batchnorm__prompt_kernel:
    s_load_dwordx2 s[8:9], s[0:1], 0
    s_load_dwordx2 s[12:13], s[0:1], 8
    v_lshrrev_b32 v1, 6, v0
    v_and_b32 v2, 63, v0
    v_readfirstlane_b32 s28, v1
    s_cmp_ge_u32 s2, 220
    s_cbranch_scc1 L_help
    s_and_b32 s3, s2, 7
    s_lshr_b32 s4, s2, 3
    s_bfe_u32 s5, s2, 0x10001
    s_mul_i32 s5, s5, 55
    s_bfe_u32 s6, s2, 0x10002
    s_mul_i32 s6, s6, 28
    s_add_u32 s4, s4, s5
    s_add_u32 s4, s4, s6
    s_mul_i32 s5, s4, 52429
    s_lshr_b32 s5, s5, 18
    s_mul_i32 s6, s5, 5
    s_sub_u32 s4, s4, s6
    s_lshr_b32 s6, s3, 2
    s_xor_b32 s6, s6, s3
    s_and_b32 s6, s6, 1
    s_mul_i32 s6, s6, 5
    s_add_u32 s30, s4, s6
    s_lshl_b32 s33, s30, 7
    s_cmp_ge_u32 s28, 4
    s_cbranch_scc1 L_compute
L_loader:
    s_add_u32 s31, s4, s5
    s_mov_b32 s29, s5
    s_mov_b32 s10, 2621440
    s_mov_b32 s11, 0x00020000
    s_mov_b32 s14, 2457600
    s_mov_b32 s15, s11
    s_mul_i32 s32, s29, 120320
    s_and_b32 s31, s31, 1
    s_mul_i32 s31, s31, 5
    s_lshl_b32 s6, s3, 2
    s_lshr_b32 s6, 0x42314130, s6
    s_and_b32 s6, s6, 15
    s_add_u32 s31, s31, s6
    v_lshrrev_b32 v3, 3, v2
    v_and_b32 v4, 7, v2
    s_lshl_b32 s5, s28, 3
    s_movk_i32 s6, 1280
    v_add_u32 v9, s5, v3
    s_and_b32 s7, s28, 1
    s_lshl_b32 s7, s7, 2
    v_and_b32 v10, 2, v3
    v_or_b32 v10, s7, v10
    v_xor_b32 v10, v10, v4
    v_lshl_add_u32 v10, v10, 4, s33
    v_mad_u32_u24 v8, v9, s6, v10
    v_and_b32 v12, 15, v9
    v_and_b32 v13, 6, v3
    v_xor_b32 v13, v13, v4
    v_lshlrev_b32 v13, 4, v13
    s_lshr_b32 s7, s28, 1
    v_mad_u32_u24 v12, v12, 6, s7
    s_sub_u32 s5, s32, 1280
    s_cmp_eq_u32 s29, 0
    s_cselect_b32 s5, 0x7f000000, s5
    v_cmp_eq_u32 vcc, 31, v9
    v_mad_u32_u24 v5, v12, s6, v13
    v_add_u32 v13, s5, v13
    v_add_u32 v5, s32, v5
    v_add_u32 v6, 2560, v5
    v_add_u32 v7, 5120, v5
    v_cndmask_b32 v7, v7, v13, vcc
    s_lshl_b32 s39, s28, 10
    s_add_u32 s34, s39, 12288
    s_lshl_b32 s35, s31, 7
    s_mul_i32 s36, s31, 81920
    s_mov_b32 s38, 0
    s_waitcnt lgkmcnt(0)
    s_mov_b32 m0, s39
    s_nop 0
    buffer_load_dwordx4 v5, s[8:11], s35 offen  lds
    s_load_dwordx2 s[24:25], s[0:1], 48
    s_add_u32 m0, s39, 4096
    s_nop 0
    buffer_load_dwordx4 v6, s[8:11], s35 offen  lds
    s_add_u32 m0, s39, 8192
    s_nop 0
    buffer_load_dwordx4 v7, s[8:11], s35 offen  lds
    s_mov_b32 m0, s34
    s_nop 0
    buffer_load_dwordx4 v8, s[12:15], s36 offen  lds
    s_mov_b32 s26, s10
    s_mov_b32 s27, s11
    s_and_b32 s40, s28, 1
    s_lshr_b32 s41, s28, 1
    s_lshl_b32 s42, s40, 3
    v_add_u32 v9, s42, v3
    v_mad_u32_u24 v10, v9, 6, s41
    v_xor_b32 v11, v4, v3
    s_add_u32 s42, s32, s33
    v_lshl_add_u32 v11, v11, 4, s42
    v_mad_u32_u24 v14, v10, s6, v11
    v_mov_b32 v12, 0x7f000000
    v_cmp_lt_u32 vcc, 14, v9
    s_lshl_b32 s41, s41, 11
    s_lshl_b32 s40, s40, 10
    s_add_u32 s40, s40, s41
    s_add_u32 s40, s40, 147456
    v_cndmask_b32 v15, v14, v12, vcc
    v_lshl_add_u32 v16, v2, 4, s40
    s_movk_i32 s40, 2560
    s_movk_i32 s41, 5120
L_lda:
    s_add_u32 s35, s35, 128
    s_cmp_eq_u32 s35, 1280
    s_cselect_b32 s35, 0, s35
    s_add_u32 m0, s34, 4096
    s_add_u32 s37, s36, 819200
    buffer_load_dwordx4 v8, s[12:15], s37 offen  lds
    s_add_u32 s39, s39, 36864
    s_cmp_ge_u32 s39, 147456
    s_cselect_b32 s7, 147456, 0
    s_sub_u32 s39, s39, s7
    s_add_u32 m0, s34, 8192
    s_add_u32 s37, s36, 1638400
    buffer_load_dwordx4 v8, s[12:15], s37 offen  lds
    s_mov_b32 m0, s39
    s_nop 0
    buffer_load_dwordx4 v5, s[8:11], s35 offen  lds
    s_add_u32 m0, s34, 12288
    s_add_u32 s37, s36, 40960
    s_cmp_eq_u32 s38, 0
    s_cbranch_scc1 L_ns0a
    s_waitcnt vmcnt(10)
    s_barrier
L_ns0a:
    buffer_load_dwordx4 v8, s[12:15], s37 offen  lds
    s_add_u32 m0, s34, 16384
    s_add_u32 s37, s36, 860160
    buffer_load_dwordx4 v8, s[12:15], s37 offen  lds
    s_add_u32 m0, s34, 20480
    s_add_u32 s37, s36, 1679360
    buffer_load_dwordx4 v8, s[12:15], s37 offen  lds
    s_mul_i32 s36, s35, 640
    s_add_u32 s34, s39, 12288
    s_add_u32 s38, s38, 1
    s_add_u32 m0, s39, 4096
    s_nop 0
    buffer_load_dwordx4 v6, s[8:11], s35 offen  lds
    s_add_u32 m0, s39, 8192
    s_nop 0
    buffer_load_dwordx4 v7, s[8:11], s35 offen  lds
    s_mov_b32 m0, s34
    s_cmp_eq_u32 s38, 1
    s_cbranch_scc1 L_ns1a
    s_waitcnt vmcnt(10)
    s_barrier
L_ns1a:
    buffer_load_dwordx4 v8, s[12:15], s36 offen  lds
    s_cmp_lt_u32 s38, 5
    s_cbranch_scc1 L_lda
    s_waitcnt vmcnt(7)
    s_barrier
L_ldb:
    s_add_u32 s35, s35, 128
    s_cmp_eq_u32 s35, 1280
    s_cselect_b32 s35, 0, s35
    s_add_u32 m0, s34, 4096
    s_add_u32 s37, s36, 819200
    buffer_load_dwordx4 v8, s[12:15], s37 offen  lds
    s_add_u32 s39, s39, 36864
    s_cmp_ge_u32 s39, 147456
    s_cselect_b32 s7, 147456, 0
    s_sub_u32 s39, s39, s7
    s_add_u32 m0, s34, 8192
    s_add_u32 s37, s36, 1638400
    buffer_load_dwordx4 v8, s[12:15], s37 offen  lds
    s_mov_b32 m0, s39
    s_nop 0
    buffer_load_dwordx4 v5, s[8:11], s35 offen  lds
    s_add_u32 m0, s34, 12288
    s_add_u32 s37, s36, 40960
    s_waitcnt vmcnt(6)
    s_barrier
L_ns0b:
    buffer_load_dwordx4 v8, s[12:15], s37 offen  lds
    s_add_u32 m0, s34, 16384
    s_add_u32 s37, s36, 860160
    buffer_load_dwordx4 v8, s[12:15], s37 offen  lds
    s_add_u32 m0, s34, 20480
    s_add_u32 s37, s36, 1679360
    buffer_load_dwordx4 v8, s[12:15], s37 offen  lds
    s_mul_i32 s36, s35, 640
    s_add_u32 s34, s39, 12288
    s_add_u32 s38, s38, 1
    s_add_u32 m0, s39, 4096
    s_nop 0
    buffer_load_dwordx4 v6, s[8:11], s35 offen  lds
    s_add_u32 m0, s39, 8192
    s_nop 0
    buffer_load_dwordx4 v7, s[8:11], s35 offen  lds
    s_mov_b32 m0, s34
    s_waitcnt vmcnt(6)
    s_barrier
L_ns1b:
    buffer_load_dwordx4 v8, s[12:15], s36 offen  lds
    s_cmp_lt_u32 s38, 9
    s_cbranch_scc1 L_ldb
    s_add_u32 m0, s34, 4096
    s_add_u32 s37, s36, 819200
    buffer_load_dwordx4 v8, s[12:15], s37 offen  lds
    s_add_u32 m0, s34, 8192
    s_add_u32 s37, s36, 1638400
    buffer_load_dwordx4 v8, s[12:15], s37 offen  lds
    s_add_u32 m0, s34, 12288
    s_add_u32 s37, s36, 40960
    s_waitcnt vmcnt(5)
    s_barrier
    buffer_load_dwordx4 v8, s[12:15], s37 offen  lds
    s_add_u32 m0, s34, 16384
    s_add_u32 s37, s36, 860160
    buffer_load_dwordx4 v8, s[12:15], s37 offen  lds
    s_add_u32 m0, s34, 20480
    s_add_u32 s37, s36, 1679360
    buffer_load_dwordx4 v8, s[12:15], s37 offen  lds
    s_waitcnt vmcnt(3)
    s_barrier
    s_waitcnt vmcnt(0)
    s_barrier
L_store:
    s_waitcnt lgkmcnt(0)
    s_barrier
    ds_read_b128 v[32:35], v16 offset:0
    s_waitcnt lgkmcnt(0)
    buffer_store_dwordx4 v[32:35], v14, s[24:27], 0 offen sc1
    s_barrier
    ds_read_b128 v[36:39], v16 offset:4096
    s_waitcnt lgkmcnt(0)
    buffer_store_dwordx4 v[36:39], v14, s[24:27], s40 offen sc1
    s_barrier
    ds_read_b128 v[40:43], v16 offset:8192
    s_waitcnt lgkmcnt(0)
    buffer_store_dwordx4 v[40:43], v15, s[24:27], s41 offen sc1
    s_endpgm
L_help:
    s_sub_u32 s4, s2, 220
    s_lshl_b32 s4, s4, 2
    s_add_u32 s4, s4, s28
    s_mov_b32 s11, 0x00020000
    s_movk_i32 s6, 1280
    s_cmp_ge_u32 s28, 4
    s_cselect_b32 s4, 136, s4
    s_cmp_ge_u32 s4, 136
    s_cbranch_scc1 L_end0
    s_cmp_ge_u32 s4, 72
    s_cbranch_scc1 L_helpw
    s_mul_i32 s5, s4, 7282
    s_lshr_b32 s5, s5, 16
    s_mul_i32 s7, s5, 9
    s_sub_u32 s4, s4, s7
    s_lshl_b32 s7, s5, 2
    s_lshr_b32 s7, 0x16830572, s7
    s_and_b32 s7, s7, 15
    s_lshl_b32 s7, s7, 7
    s_lshr_b32 s5, s5, 1
L_helpx:
    s_mul_i32 s5, s5, 517
    s_mul_i32 s4, s4, 59
    s_add_u32 s4, s4, s5
    s_mul_i32 s4, s4, 1280
    s_add_u32 s4, s4, s7
    v_min_u32 v2, 58, v2
    v_mul_u32_u24 v3, s6, v2
    s_mov_b32 s10, 2621440
    s_waitcnt lgkmcnt(0)
    buffer_load_dword v4, v3, s[8:11], s4 offen
L_end0:
    s_endpgm
L_helpw:
    s_sub_u32 s4, s4, 72
    s_lshr_b32 s5, s4, 4
    s_and_b32 s4, s4, 15
    s_mul_i32 s4, s4, 12
    v_min_u32 v2, 59, v2
    v_mul_u32_u24 v3, 52429, v2
    v_lshrrev_b32 v3, 18, v3
    v_mad_i32_i24 v2, v3, -5, v2
    v_add_u32 v3, s4, v3
    v_lshrrev_b32 v4, 6, v3
    v_mul_u32_u24 v4, 576, v4
    v_add_u32 v3, v3, v4
    v_lshlrev_b32 v2, 7, v2
    v_mad_u32_u24 v3, v3, s6, v2
    s_lshl_b32 s7, s5, 2
    s_lshr_b32 s7, 0x5072, s7
    s_and_b32 s7, s7, 15
    s_mul_i32 s7, s7, 81920
    s_lshr_b32 s5, s5, 1
    s_mul_i32 s5, s5, 640
    s_add_u32 s4, s5, s7
    s_mov_b32 s14, 2457600
    s_mov_b32 s15, s11
    s_waitcnt lgkmcnt(0)
    buffer_load_dword v4, v3, s[12:15], s4 offen
    s_endpgm
L_help_end:
.p2align 12
L_compute:
    s_sub_u32 s28, s28, 4
    s_load_dwordx8 s[16:23], s[0:1], 16
    s_lshl_b32 s5, s28, 5
    s_add_u32 s5, s5, s33
    s_waitcnt lgkmcnt(0)
    s_load_dwordx8 s[36:43], s[16:17], s5
    s_load_dwordx8 s[44:51], s[18:19], s5
    s_load_dwordx8 s[52:59], s[20:21], s5
    s_load_dwordx8 s[60:67], s[22:23], s5
L_compute2:
    v_and_b32 v3, 15, v2
    v_lshrrev_b32 v4, 4, v2
    v_and_b32 v6, 6, v3
    v_xor_b32 v6, v6, v4
    v_lshlrev_b32 v6, 4, v6
    v_lshl_add_u32 v120, v3, 7, v6
    v_xor_b32 v123, 64, v120
    v_add_u32 v5, -1, v3
    v_and_b32 v5, 15, v5
    v_and_b32 v6, 6, v5
    v_xor_b32 v6, v6, v4
    v_lshlrev_b32 v6, 4, v6
    v_lshl_add_u32 v121, v5, 7, v6
    v_add_u32 v121, 10240, v121
    v_xor_b32 v124, 64, v121
    v_add_u32 v5, 1, v3
    v_and_b32 v6, 6, v5
    v_xor_b32 v6, v6, v4
    v_lshlrev_b32 v6, 4, v6
    v_lshl_add_u32 v122, v5, 7, v6
    v_xor_b32 v125, 64, v122
    v_bfe_u32 v5, v2, 2, 2
    v_lshl_add_u32 v6, v4, 3, v5
    v_and_b32 v5, 2, v5
    v_and_b32 v7, 1, v4
    v_lshl_or_b32 v5, v7, 2, v5
    v_bfe_u32 v7, v2, 1, 1
    s_lshl_b32 s5, s28, 1
    v_or_b32 v7, s5, v7
    v_xor_b32 v5, v5, v7
    v_lshlrev_b32 v5, 4, v5
    v_lshl_add_u32 v5, v6, 7, v5
    v_and_b32 v7, 1, v2
    v_lshl_add_u32 v126, v7, 3, v5
    v_add_u32 v126, 12288, v126
    v_lshrrev_b32 v5, 1, v4
    v_or_b32 v5, s5, v5
    v_and_b32 v6, 7, v3
    v_xor_b32 v5, v5, v6
    v_lshlrev_b32 v5, 4, v5
    v_lshl_add_u32 v5, v3, 7, v5
    v_and_b32 v6, 1, v4
    v_lshl_add_u32 v5, v6, 3, v5
    v_add_u32 v127, 147456, v5
    v_mov_b64 v[8:9], 0
    v_mov_b64 v[10:11], 0
    v_mov_b64 v[12:13], 0
    v_mov_b64 v[14:15], 0
    v_mov_b64 v[16:17], 0
    v_mov_b64 v[18:19], 0
    v_mov_b64 v[20:21], 0
    v_mov_b64 v[22:23], 0
    v_mov_b64 v[24:25], 0
    v_mov_b64 v[26:27], 0
    v_mov_b64 v[28:29], 0
    v_mov_b64 v[30:31], 0
    s_mov_b32 s34, 3
    s_mov_b32 s32, 73728
    s_mov_b32 s35, 0
    s_mov_b32 s33, 0xfffe5000
    s_mov_b32 s6, 0xbfb8aa3b
    s_mov_b32 s7, s6
    s_mov_b32 s5, 0xffff0000
    s_mov_b32 s4, 0x3727c5ac
    s_waitcnt lgkmcnt(0)
    v_mov_b64 v[80:81], s[36:37]
    v_mov_b64 v[82:83], s[44:45]
    v_mov_b64 v[84:85], s[52:53]
    v_mov_b64 v[86:87], s[60:61]
    s_mov_b32 exec_lo, s5
    v_mov_b64 v[80:81], s[38:39]
    v_mov_b64 v[82:83], s[46:47]
    v_mov_b64 v[84:85], s[54:55]
    v_mov_b64 v[86:87], s[62:63]
    s_mov_b32 exec_lo, 0
    v_mov_b64 v[80:81], s[40:41]
    v_mov_b64 v[82:83], s[48:49]
    v_mov_b64 v[84:85], s[56:57]
    v_mov_b64 v[86:87], s[64:65]
    s_mov_b32 exec_hi, s5
    v_mov_b64 v[80:81], s[42:43]
    v_mov_b64 v[82:83], s[50:51]
    v_mov_b64 v[84:85], s[58:59]
    v_mov_b64 v[86:87], s[66:67]
    s_mov_b64 exec, -1
    v_lshlrev_b32 v128, 16, v82
    v_and_b32 v129, s5, v82
    v_lshlrev_b32 v130, 16, v83
    v_and_b32 v131, s5, v83
    v_add_f32 v128, s4, v128
    v_add_f32 v129, s4, v129
    v_add_f32 v130, s4, v130
    v_add_f32 v131, s4, v131
    v_cvt_pk_bf16_f32 v78, v128, v129
    v_cvt_pk_bf16_f32 v79, v130, v131
    v_lshlrev_b32 v128, 16, v78
    v_and_b32 v129, s5, v78
    v_lshlrev_b32 v130, 16, v79
    v_and_b32 v131, s5, v79
    v_sqrt_f32 v128, v128
    v_sqrt_f32 v129, v129
    v_sqrt_f32 v130, v130
    v_sqrt_f32 v131, v131
    v_lshlrev_b32 v88, 16, v84
    v_and_b32 v89, s5, v84
    v_lshlrev_b32 v90, 16, v85
    v_and_b32 v91, s5, v85
    v_cvt_pk_bf16_f32 v78, v128, v129
    v_cvt_pk_bf16_f32 v79, v130, v131
    v_lshlrev_b32 v128, 16, v78
    v_and_b32 v129, s5, v78
    v_lshlrev_b32 v130, 16, v79
    v_and_b32 v131, s5, v79
    v_rcp_f32 v128, v128
    v_rcp_f32 v129, v129
    v_rcp_f32 v130, v130
    v_rcp_f32 v131, v131
    v_lshlrev_b32 v92, 16, v80
    v_and_b32 v93, s5, v80
    v_lshlrev_b32 v94, 16, v81
    v_and_b32 v95, s5, v81
    v_cvt_pk_bf16_f32 v78, v128, v129
    v_cvt_pk_bf16_f32 v79, v130, v131
    v_lshlrev_b32 v128, 16, v78
    v_and_b32 v129, s5, v78
    v_lshlrev_b32 v130, 16, v79
    v_and_b32 v131, s5, v79
    v_pk_mul_f32 v[128:129], v[128:129], v[88:89]
    v_pk_mul_f32 v[130:131], v[130:131], v[90:91]
    v_lshlrev_b32 v132, 16, v86
    v_and_b32 v133, s5, v86
    v_lshlrev_b32 v134, 16, v87
    v_and_b32 v135, s5, v87
    v_cvt_pk_bf16_f32 v78, v128, v129
    v_cvt_pk_bf16_f32 v79, v130, v131
    v_lshlrev_b32 v128, 16, v78
    v_and_b32 v129, s5, v78
    v_lshlrev_b32 v130, 16, v79
    v_and_b32 v131, s5, v79
    v_fma_f32 v132, -v92, v128, v132
    v_fma_f32 v133, -v93, v129, v133
    v_fma_f32 v134, -v94, v130, v134
    v_fma_f32 v135, -v95, v131, v135
    v_pk_mul_f32 v[128:129], v[128:129], s[6:7]
    v_pk_mul_f32 v[130:131], v[130:131], s[6:7]
    v_pk_mul_f32 v[132:133], v[132:133], s[6:7]
    v_pk_mul_f32 v[134:135], v[134:135], s[6:7]
    s_barrier
    ds_read_b64_tr_b16 v[64:65], v126 offset:0
    ds_read_b64_tr_b16 v[66:67], v126 offset:512
    ds_read_b128 v[32:35], v121 offset:0
    ds_read_b64_tr_b16 v[68:69], v126 offset:4096
    ds_read_b64_tr_b16 v[70:71], v126 offset:4608
    ds_read_b128 v[36:39], v120 offset:0
    ds_read_b64_tr_b16 v[72:73], v126 offset:8192
    ds_read_b64_tr_b16 v[74:75], v126 offset:8704
    ds_read_b128 v[40:43], v120 offset:2048
    ds_read_b128 v[44:47], v120 offset:4096
L_cloop:
    s_waitcnt lgkmcnt(4)
    v_mfma_f32_16x16x32_bf16 v[8:11], v[64:67], v[32:35], v[8:11]
    ds_read_b128 v[48:51], v120 offset:6144
    v_mfma_f32_16x16x32_bf16 v[8:11], v[68:71], v[36:39], v[8:11]
    s_waitcnt lgkmcnt(1)
    v_mfma_f32_16x16x32_bf16 v[8:11], v[72:75], v[40:43], v[8:11]
    ds_read_b128 v[52:55], v120 offset:8192
    v_mfma_f32_16x16x32_bf16 v[12:15], v[64:67], v[36:39], v[12:15]
    ds_read_b128 v[56:59], v120 offset:10240
    v_mfma_f32_16x16x32_bf16 v[12:15], v[68:71], v[40:43], v[12:15]
    v_mfma_f32_16x16x32_bf16 v[12:15], v[72:75], v[44:47], v[12:15]
    ds_read_b128 v[60:63], v122 offset:0
    v_mfma_f32_16x16x32_bf16 v[16:19], v[64:67], v[40:43], v[16:19]
    s_barrier
    ds_read_b64_tr_b16 v[108:109], v126 offset:12288
    v_mfma_f32_16x16x32_bf16 v[16:19], v[68:71], v[44:47], v[16:19]
    ds_read_b64_tr_b16 v[110:111], v126 offset:12800
    ds_read_b128 v[76:79], v124 offset:0
    s_waitcnt lgkmcnt(5)
    v_mfma_f32_16x16x32_bf16 v[16:19], v[72:75], v[48:51], v[16:19]
    ds_read_b64_tr_b16 v[112:113], v126 offset:16384
    v_mfma_f32_16x16x32_bf16 v[20:23], v[64:67], v[44:47], v[20:23]
    ds_read_b64_tr_b16 v[114:115], v126 offset:16896
    v_mfma_f32_16x16x32_bf16 v[20:23], v[68:71], v[48:51], v[20:23]
    ds_read_b128 v[80:83], v123 offset:0
    v_mfma_f32_16x16x32_bf16 v[20:23], v[72:75], v[52:55], v[20:23]
    ds_read_b64_tr_b16 v[116:117], v126 offset:20480
    v_mfma_f32_16x16x32_bf16 v[24:27], v[64:67], v[48:51], v[24:27]
    ds_read_b64_tr_b16 v[118:119], v126 offset:20992
    v_mfma_f32_16x16x32_bf16 v[24:27], v[68:71], v[52:55], v[24:27]
    ds_read_b128 v[84:87], v123 offset:2048
    s_waitcnt lgkmcnt(9)
    v_mfma_f32_16x16x32_bf16 v[24:27], v[72:75], v[56:59], v[24:27]
    ds_read_b128 v[88:91], v123 offset:4096
    v_mfma_f32_16x16x32_bf16 v[28:31], v[64:67], v[52:55], v[28:31]
    v_mfma_f32_16x16x32_bf16 v[28:31], v[68:71], v[56:59], v[28:31]
    v_mfma_f32_16x16x32_bf16 v[28:31], v[72:75], v[60:63], v[28:31]
    s_waitcnt lgkmcnt(4)
    v_mfma_f32_16x16x32_bf16 v[8:11], v[108:111], v[76:79], v[8:11]
    ds_read_b128 v[92:95], v123 offset:6144
    v_mfma_f32_16x16x32_bf16 v[8:11], v[112:115], v[80:83], v[8:11]
    s_waitcnt lgkmcnt(1)
    v_mfma_f32_16x16x32_bf16 v[8:11], v[116:119], v[84:87], v[8:11]
    ds_read_b128 v[96:99], v123 offset:8192
    v_mfma_f32_16x16x32_bf16 v[12:15], v[108:111], v[80:83], v[12:15]
    ds_read_b128 v[100:103], v123 offset:10240
    v_mfma_f32_16x16x32_bf16 v[12:15], v[112:115], v[84:87], v[12:15]
    v_mfma_f32_16x16x32_bf16 v[12:15], v[116:119], v[88:91], v[12:15]
    ds_read_b128 v[104:107], v125 offset:0
    v_mfma_f32_16x16x32_bf16 v[16:19], v[108:111], v[84:87], v[16:19]
    s_barrier
    ds_read_b64_tr_b16 v[64:65], v126 offset:36864
    v_mfma_f32_16x16x32_bf16 v[16:19], v[112:115], v[88:91], v[16:19]
    ds_read_b64_tr_b16 v[66:67], v126 offset:37376
    ds_read_b128 v[32:35], v121 offset:36864
    s_waitcnt lgkmcnt(5)
    v_mfma_f32_16x16x32_bf16 v[16:19], v[116:119], v[92:95], v[16:19]
    ds_read_b64_tr_b16 v[68:69], v126 offset:40960
    v_mfma_f32_16x16x32_bf16 v[20:23], v[108:111], v[88:91], v[20:23]
    ds_read_b64_tr_b16 v[70:71], v126 offset:41472
    v_mfma_f32_16x16x32_bf16 v[20:23], v[112:115], v[92:95], v[20:23]
    ds_read_b128 v[36:39], v120 offset:36864
    v_mfma_f32_16x16x32_bf16 v[20:23], v[116:119], v[96:99], v[20:23]
    ds_read_b64_tr_b16 v[72:73], v126 offset:45056
    v_mfma_f32_16x16x32_bf16 v[24:27], v[108:111], v[92:95], v[24:27]
    ds_read_b64_tr_b16 v[74:75], v126 offset:45568
    v_mfma_f32_16x16x32_bf16 v[24:27], v[112:115], v[96:99], v[24:27]
    ds_read_b128 v[40:43], v120 offset:38912
    s_waitcnt lgkmcnt(9)
    v_mfma_f32_16x16x32_bf16 v[24:27], v[116:119], v[100:103], v[24:27]
    ds_read_b128 v[44:47], v120 offset:40960
    v_mfma_f32_16x16x32_bf16 v[28:31], v[108:111], v[96:99], v[28:31]
    v_mfma_f32_16x16x32_bf16 v[28:31], v[112:115], v[100:103], v[28:31]
    v_mfma_f32_16x16x32_bf16 v[28:31], v[116:119], v[104:107], v[28:31]
    s_waitcnt lgkmcnt(4)
    v_mfma_f32_16x16x32_bf16 v[8:11], v[64:67], v[32:35], v[8:11]
    ds_read_b128 v[48:51], v120 offset:43008
    v_mfma_f32_16x16x32_bf16 v[8:11], v[68:71], v[36:39], v[8:11]
    s_waitcnt lgkmcnt(1)
    v_mfma_f32_16x16x32_bf16 v[8:11], v[72:75], v[40:43], v[8:11]
    ds_read_b128 v[52:55], v120 offset:45056
    v_mfma_f32_16x16x32_bf16 v[12:15], v[64:67], v[36:39], v[12:15]
    ds_read_b128 v[56:59], v120 offset:47104
    v_mfma_f32_16x16x32_bf16 v[12:15], v[68:71], v[40:43], v[12:15]
    v_mfma_f32_16x16x32_bf16 v[12:15], v[72:75], v[44:47], v[12:15]
    ds_read_b128 v[60:63], v122 offset:36864
    v_mfma_f32_16x16x32_bf16 v[16:19], v[64:67], v[40:43], v[16:19]
    s_barrier
    ds_read_b64_tr_b16 v[108:109], v126 offset:49152
    v_mfma_f32_16x16x32_bf16 v[16:19], v[68:71], v[44:47], v[16:19]
    ds_read_b64_tr_b16 v[110:111], v126 offset:49664
    ds_read_b128 v[76:79], v124 offset:36864
    s_waitcnt lgkmcnt(5)
    v_mfma_f32_16x16x32_bf16 v[16:19], v[72:75], v[48:51], v[16:19]
    ds_read_b64_tr_b16 v[112:113], v126 offset:53248
    v_mfma_f32_16x16x32_bf16 v[20:23], v[64:67], v[44:47], v[20:23]
    ds_read_b64_tr_b16 v[114:115], v126 offset:53760
    v_mfma_f32_16x16x32_bf16 v[20:23], v[68:71], v[48:51], v[20:23]
    ds_read_b128 v[80:83], v123 offset:36864
    v_mfma_f32_16x16x32_bf16 v[20:23], v[72:75], v[52:55], v[20:23]
    ds_read_b64_tr_b16 v[116:117], v126 offset:57344
    v_mfma_f32_16x16x32_bf16 v[24:27], v[64:67], v[48:51], v[24:27]
    ds_read_b64_tr_b16 v[118:119], v126 offset:57856
    v_mfma_f32_16x16x32_bf16 v[24:27], v[68:71], v[52:55], v[24:27]
    ds_read_b128 v[84:87], v123 offset:38912
    s_waitcnt lgkmcnt(9)
    v_mfma_f32_16x16x32_bf16 v[24:27], v[72:75], v[56:59], v[24:27]
    ds_read_b128 v[88:91], v123 offset:40960
    v_mfma_f32_16x16x32_bf16 v[28:31], v[64:67], v[52:55], v[28:31]
    v_add_u32 v121, s32, v121
    v_add_u32 v120, s32, v120
    v_mfma_f32_16x16x32_bf16 v[28:31], v[68:71], v[56:59], v[28:31]
    v_add_u32 v122, s32, v122
    v_add_u32 v126, s32, v126
    v_mfma_f32_16x16x32_bf16 v[28:31], v[72:75], v[60:63], v[28:31]
    s_waitcnt lgkmcnt(4)
    v_mfma_f32_16x16x32_bf16 v[8:11], v[108:111], v[76:79], v[8:11]
    ds_read_b128 v[92:95], v123 offset:43008
    s_sub_u32 s34, s34, 1
    v_mfma_f32_16x16x32_bf16 v[8:11], v[112:115], v[80:83], v[8:11]
    s_waitcnt lgkmcnt(1)
    v_mfma_f32_16x16x32_bf16 v[8:11], v[116:119], v[84:87], v[8:11]
    ds_read_b128 v[96:99], v123 offset:45056
    v_mfma_f32_16x16x32_bf16 v[12:15], v[108:111], v[80:83], v[12:15]
    ds_read_b128 v[100:103], v123 offset:47104
    v_mfma_f32_16x16x32_bf16 v[12:15], v[112:115], v[84:87], v[12:15]
    v_add_u32 v123, s32, v123
    v_add_u32 v124, s32, v124
    v_mfma_f32_16x16x32_bf16 v[12:15], v[116:119], v[88:91], v[12:15]
    ds_read_b128 v[104:107], v125 offset:36864
    v_mfma_f32_16x16x32_bf16 v[16:19], v[108:111], v[84:87], v[16:19]
    s_barrier
    ds_read_b64_tr_b16 v[64:65], v126 offset:0
    v_mfma_f32_16x16x32_bf16 v[16:19], v[112:115], v[88:91], v[16:19]
    ds_read_b64_tr_b16 v[66:67], v126 offset:512
    ds_read_b128 v[32:35], v121 offset:0
    s_waitcnt lgkmcnt(5)
    v_mfma_f32_16x16x32_bf16 v[16:19], v[116:119], v[92:95], v[16:19]
    ds_read_b64_tr_b16 v[68:69], v126 offset:4096
    v_mfma_f32_16x16x32_bf16 v[20:23], v[108:111], v[88:91], v[20:23]
    ds_read_b64_tr_b16 v[70:71], v126 offset:4608
    v_mfma_f32_16x16x32_bf16 v[20:23], v[112:115], v[92:95], v[20:23]
    ds_read_b128 v[36:39], v120 offset:0
    v_mfma_f32_16x16x32_bf16 v[20:23], v[116:119], v[96:99], v[20:23]
    ds_read_b64_tr_b16 v[72:73], v126 offset:8192
    v_mfma_f32_16x16x32_bf16 v[24:27], v[108:111], v[92:95], v[24:27]
    ds_read_b64_tr_b16 v[74:75], v126 offset:8704
    v_mfma_f32_16x16x32_bf16 v[24:27], v[112:115], v[96:99], v[24:27]
    ds_read_b128 v[40:43], v120 offset:2048
    s_waitcnt lgkmcnt(9)
    v_mfma_f32_16x16x32_bf16 v[24:27], v[116:119], v[100:103], v[24:27]
    ds_read_b128 v[44:47], v120 offset:4096
    v_mfma_f32_16x16x32_bf16 v[28:31], v[108:111], v[96:99], v[28:31]
    v_add_u32 v125, s32, v125
    v_mfma_f32_16x16x32_bf16 v[28:31], v[112:115], v[100:103], v[28:31]
    s_mul_i32 s32, s32, -1
    v_mfma_f32_16x16x32_bf16 v[28:31], v[116:119], v[104:107], v[28:31]
    s_cbranch_scc0 L_cloop
    s_waitcnt lgkmcnt(4)
    v_mfma_f32_16x16x32_bf16 v[8:11], v[64:67], v[32:35], v[8:11]
    ds_read_b128 v[48:51], v120 offset:6144
    v_mfma_f32_16x16x32_bf16 v[8:11], v[68:71], v[36:39], v[8:11]
    s_waitcnt lgkmcnt(1)
    v_mfma_f32_16x16x32_bf16 v[8:11], v[72:75], v[40:43], v[8:11]
    ds_read_b128 v[52:55], v120 offset:8192
    v_mfma_f32_16x16x32_bf16 v[12:15], v[64:67], v[36:39], v[12:15]
    ds_read_b128 v[56:59], v120 offset:10240
    v_mfma_f32_16x16x32_bf16 v[12:15], v[68:71], v[40:43], v[12:15]
    v_mfma_f32_16x16x32_bf16 v[12:15], v[72:75], v[44:47], v[12:15]
    ds_read_b128 v[60:63], v122 offset:0
    v_mfma_f32_16x16x32_bf16 v[16:19], v[64:67], v[40:43], v[16:19]
    s_barrier
    ds_read_b64_tr_b16 v[108:109], v126 offset:12288
    v_mfma_f32_16x16x32_bf16 v[16:19], v[68:71], v[44:47], v[16:19]
    ds_read_b64_tr_b16 v[110:111], v126 offset:12800
    ds_read_b128 v[76:79], v124 offset:0
    s_waitcnt lgkmcnt(5)
    v_mfma_f32_16x16x32_bf16 v[16:19], v[72:75], v[48:51], v[16:19]
    ds_read_b64_tr_b16 v[112:113], v126 offset:16384
    v_mfma_f32_16x16x32_bf16 v[20:23], v[64:67], v[44:47], v[20:23]
    ds_read_b64_tr_b16 v[114:115], v126 offset:16896
    v_mfma_f32_16x16x32_bf16 v[20:23], v[68:71], v[48:51], v[20:23]
    ds_read_b128 v[80:83], v123 offset:0
    v_mfma_f32_16x16x32_bf16 v[20:23], v[72:75], v[52:55], v[20:23]
    ds_read_b64_tr_b16 v[116:117], v126 offset:20480
    v_mfma_f32_16x16x32_bf16 v[24:27], v[64:67], v[48:51], v[24:27]
    ds_read_b64_tr_b16 v[118:119], v126 offset:20992
    v_mfma_f32_16x16x32_bf16 v[24:27], v[68:71], v[52:55], v[24:27]
    ds_read_b128 v[84:87], v123 offset:2048
    s_waitcnt lgkmcnt(9)
    v_mfma_f32_16x16x32_bf16 v[24:27], v[72:75], v[56:59], v[24:27]
    ds_read_b128 v[88:91], v123 offset:4096
    v_mfma_f32_16x16x32_bf16 v[28:31], v[64:67], v[52:55], v[28:31]
    v_mfma_f32_16x16x32_bf16 v[28:31], v[68:71], v[56:59], v[28:31]
    v_mfma_f32_16x16x32_bf16 v[28:31], v[72:75], v[60:63], v[28:31]
    s_waitcnt lgkmcnt(4)
    v_mfma_f32_16x16x32_bf16 v[8:11], v[108:111], v[76:79], v[8:11]
    ds_read_b128 v[92:95], v123 offset:6144
    v_mfma_f32_16x16x32_bf16 v[8:11], v[112:115], v[80:83], v[8:11]
    s_waitcnt lgkmcnt(1)
    v_mfma_f32_16x16x32_bf16 v[8:11], v[116:119], v[84:87], v[8:11]
    ds_read_b128 v[96:99], v123 offset:8192
    v_mfma_f32_16x16x32_bf16 v[12:15], v[108:111], v[80:83], v[12:15]
    ds_read_b128 v[100:103], v123 offset:10240
    v_mfma_f32_16x16x32_bf16 v[12:15], v[112:115], v[84:87], v[12:15]
    v_mfma_f32_16x16x32_bf16 v[12:15], v[116:119], v[88:91], v[12:15]
    ds_read_b128 v[104:107], v125 offset:0
    v_mfma_f32_16x16x32_bf16 v[16:19], v[108:111], v[84:87], v[16:19]
    s_barrier
    ds_read_b64_tr_b16 v[64:65], v126 offset:36864
    v_mfma_f32_16x16x32_bf16 v[16:19], v[112:115], v[88:91], v[16:19]
    ds_read_b64_tr_b16 v[66:67], v126 offset:37376
    ds_read_b128 v[32:35], v121 offset:36864
    s_waitcnt lgkmcnt(5)
    v_mfma_f32_16x16x32_bf16 v[16:19], v[116:119], v[92:95], v[16:19]
    ds_read_b64_tr_b16 v[68:69], v126 offset:40960
    v_mfma_f32_16x16x32_bf16 v[20:23], v[108:111], v[88:91], v[20:23]
    ds_read_b64_tr_b16 v[70:71], v126 offset:41472
    v_mfma_f32_16x16x32_bf16 v[20:23], v[112:115], v[92:95], v[20:23]
    ds_read_b128 v[36:39], v120 offset:36864
    v_mfma_f32_16x16x32_bf16 v[20:23], v[116:119], v[96:99], v[20:23]
    ds_read_b64_tr_b16 v[72:73], v126 offset:45056
    v_mfma_f32_16x16x32_bf16 v[24:27], v[108:111], v[92:95], v[24:27]
    ds_read_b64_tr_b16 v[74:75], v126 offset:45568
    v_mfma_f32_16x16x32_bf16 v[24:27], v[112:115], v[96:99], v[24:27]
    ds_read_b128 v[40:43], v120 offset:38912
    s_waitcnt lgkmcnt(9)
    v_mfma_f32_16x16x32_bf16 v[24:27], v[116:119], v[100:103], v[24:27]
    ds_read_b128 v[44:47], v120 offset:40960
    v_mfma_f32_16x16x32_bf16 v[28:31], v[108:111], v[96:99], v[28:31]
    v_mfma_f32_16x16x32_bf16 v[28:31], v[112:115], v[100:103], v[28:31]
    v_mfma_f32_16x16x32_bf16 v[28:31], v[116:119], v[104:107], v[28:31]
    s_waitcnt lgkmcnt(4)
    v_mfma_f32_16x16x32_bf16 v[8:11], v[64:67], v[32:35], v[8:11]
    ds_read_b128 v[48:51], v120 offset:43008
    v_mfma_f32_16x16x32_bf16 v[8:11], v[68:71], v[36:39], v[8:11]
    s_waitcnt lgkmcnt(1)
    v_mfma_f32_16x16x32_bf16 v[8:11], v[72:75], v[40:43], v[8:11]
    ds_read_b128 v[52:55], v120 offset:45056
    v_mfma_f32_16x16x32_bf16 v[12:15], v[64:67], v[36:39], v[12:15]
    ds_read_b128 v[56:59], v120 offset:47104
    v_mfma_f32_16x16x32_bf16 v[12:15], v[68:71], v[40:43], v[12:15]
    v_mfma_f32_16x16x32_bf16 v[12:15], v[72:75], v[44:47], v[12:15]
    ds_read_b128 v[60:63], v122 offset:36864
    v_mfma_f32_16x16x32_bf16 v[16:19], v[64:67], v[40:43], v[16:19]
    s_barrier
    ds_read_b64_tr_b16 v[108:109], v126 offset:49152
    ds_read_b64_tr_b16 v[110:111], v126 offset:49664
    v_mfma_f32_16x16x32_bf16 v[16:19], v[68:71], v[44:47], v[16:19]
    ds_read_b128 v[76:79], v124 offset:36864
    ds_read_b64_tr_b16 v[112:113], v126 offset:53248
    s_waitcnt lgkmcnt(6)
    v_mfma_f32_16x16x32_bf16 v[16:19], v[72:75], v[48:51], v[16:19]
    ds_read_b64_tr_b16 v[114:115], v126 offset:53760
    ds_read_b128 v[80:83], v123 offset:36864
    v_mfma_f32_16x16x32_bf16 v[20:23], v[64:67], v[44:47], v[20:23]
    ds_read_b64_tr_b16 v[116:117], v126 offset:57344
    ds_read_b64_tr_b16 v[118:119], v126 offset:57856
    v_mfma_f32_16x16x32_bf16 v[20:23], v[68:71], v[48:51], v[20:23]
    ds_read_b128 v[84:87], v123 offset:38912
    ds_read_b128 v[88:91], v123 offset:40960
    v_mfma_f32_16x16x32_bf16 v[20:23], v[72:75], v[52:55], v[20:23]
    s_waitcnt lgkmcnt(4)
    v_mfma_f32_16x16x32_bf16 v[8:11], v[108:111], v[76:79], v[8:11]
    ds_read_b128 v[92:95], v123 offset:43008
    v_mfma_f32_16x16x32_bf16 v[8:11], v[112:115], v[80:83], v[8:11]
    ds_read_b128 v[96:99], v123 offset:45056
    s_waitcnt lgkmcnt(2)
    v_mfma_f32_16x16x32_bf16 v[8:11], v[116:119], v[84:87], v[8:11]
    ds_read_b128 v[100:103], v123 offset:47104
    v_mfma_f32_16x16x32_bf16 v[12:15], v[108:111], v[80:83], v[12:15]
    ds_read_b128 v[104:107], v125 offset:36864
    v_mfma_f32_16x16x32_bf16 v[12:15], v[112:115], v[84:87], v[12:15]
    v_mfma_f32_16x16x32_bf16 v[12:15], v[116:119], v[88:91], v[12:15]
    s_waitcnt lgkmcnt(2)
    v_mfma_f32_16x16x32_bf16 v[16:19], v[108:111], v[84:87], v[16:19]
    v_mfma_f32_16x16x32_bf16 v[16:19], v[112:115], v[88:91], v[16:19]
    v_mfma_f32_16x16x32_bf16 v[16:19], v[116:119], v[92:95], v[16:19]
    s_nop 1
.p2align 3
    v_pk_fma_f32 v[8:9], v[8:9], v[128:129], v[132:133]
    v_pk_fma_f32 v[10:11], v[10:11], v[130:131], v[134:135]
    v_pk_fma_f32 v[12:13], v[12:13], v[128:129], v[132:133]
    v_pk_fma_f32 v[14:15], v[14:15], v[130:131], v[134:135]
    v_mfma_f32_16x16x32_bf16 v[20:23], v[108:111], v[88:91], v[20:23]
    v_exp_f32 v136, v8
    v_exp_f32 v137, v9
    v_mfma_f32_16x16x32_bf16 v[24:27], v[64:67], v[48:51], v[24:27]
    v_exp_f32 v138, v10
    v_exp_f32 v139, v11
    v_mfma_f32_16x16x32_bf16 v[28:31], v[64:67], v[52:55], v[28:31]
    v_exp_f32 v140, v12
    v_exp_f32 v141, v13
    v_mfma_f32_16x16x32_bf16 v[20:23], v[112:115], v[92:95], v[20:23]
    v_exp_f32 v142, v14
    v_exp_f32 v143, v15
    v_mfma_f32_16x16x32_bf16 v[24:27], v[68:71], v[52:55], v[24:27]
    v_pk_fma_f32 v[136:137], v[136:137], s[6:7], s[6:7]
    v_pk_fma_f32 v[138:139], v[138:139], s[6:7], s[6:7]
    v_pk_fma_f32 v[140:141], v[140:141], s[6:7], s[6:7]
    v_pk_fma_f32 v[142:143], v[142:143], s[6:7], s[6:7]
    v_mfma_f32_16x16x32_bf16 v[28:31], v[68:71], v[56:59], v[28:31]
    v_rcp_f32 v136, v136
    v_rcp_f32 v137, v137
    v_mfma_f32_16x16x32_bf16 v[20:23], v[116:119], v[96:99], v[20:23]
    v_rcp_f32 v138, v138
    v_rcp_f32 v139, v139
    v_mfma_f32_16x16x32_bf16 v[24:27], v[72:75], v[56:59], v[24:27]
    v_rcp_f32 v140, v140
    v_rcp_f32 v141, v141
    v_rcp_f32 v142, v142
    s_waitcnt lgkmcnt(0)
    v_rcp_f32_e64 v143, v143
    v_pk_mul_f32 v[8:9], v[8:9], v[136:137]
    v_pk_mul_f32 v[10:11], v[10:11], v[138:139]
    v_cvt_pk_bf16_f32 v144, v8, v9
    v_cvt_pk_bf16_f32 v145, v10, v11
    v_pk_mul_f32 v[12:13], v[12:13], v[140:141]
    ds_write_b64 v127, v[144:145] offset:0
    v_pk_mul_f32 v[14:15], v[14:15], v[142:143]
    v_cvt_pk_bf16_f32 v146, v12, v13
    v_cvt_pk_bf16_f32 v147, v14, v15
    ds_write_b64 v127, v[146:147] offset:2048
    v_pk_fma_f32 v[16:17], v[16:17], v[128:129], v[132:133]
    v_pk_fma_f32 v[18:19], v[18:19], v[130:131], v[134:135]
    v_pk_fma_f32 v[20:21], v[20:21], v[128:129], v[132:133]
    v_pk_fma_f32 v[22:23], v[22:23], v[130:131], v[134:135]
    v_mfma_f32_16x16x32_bf16 v[24:27], v[108:111], v[92:95], v[24:27]
    v_exp_f32 v136, v16
    v_exp_f32 v137, v17
    v_mfma_f32_16x16x32_bf16 v[28:31], v[72:75], v[60:63], v[28:31]
    v_exp_f32 v138, v18
    v_exp_f32 v139, v19
    v_mfma_f32_16x16x32_bf16 v[24:27], v[112:115], v[96:99], v[24:27]
    v_exp_f32 v140, v20
    v_exp_f32 v141, v21
    v_mfma_f32_16x16x32_bf16 v[28:31], v[108:111], v[96:99], v[28:31]
    v_exp_f32 v142, v22
    v_exp_f32 v143, v23
    v_mfma_f32_16x16x32_bf16 v[24:27], v[116:119], v[100:103], v[24:27]
    v_pk_fma_f32 v[136:137], v[136:137], s[6:7], s[6:7]
    s_waitcnt lgkmcnt(0)
    s_barrier
    v_pk_fma_f32 v[138:139], v[138:139], s[6:7], s[6:7]
    v_pk_fma_f32 v[140:141], v[140:141], s[6:7], s[6:7]
    v_pk_fma_f32 v[142:143], v[142:143], s[6:7], s[6:7]
    v_mfma_f32_16x16x32_bf16 v[28:31], v[112:115], v[100:103], v[28:31]
    v_rcp_f32 v136, v136
    v_rcp_f32 v137, v137
    v_mfma_f32_16x16x32_bf16 v[28:31], v[116:119], v[104:107], v[28:31]
    v_rcp_f32 v138, v138
    v_rcp_f32 v139, v139
    v_rcp_f32 v140, v140
    v_rcp_f32 v141, v141
    v_rcp_f32 v142, v142
    v_rcp_f32 v143, v143
    v_pk_mul_f32 v[16:17], v[16:17], v[136:137]
    v_pk_mul_f32 v[18:19], v[18:19], v[138:139]
    v_cvt_pk_bf16_f32 v148, v16, v17
    v_cvt_pk_bf16_f32 v149, v18, v19
    v_pk_mul_f32 v[20:21], v[20:21], v[140:141]
    ds_write_b64 v127, v[148:149] offset:4096
    v_pk_mul_f32 v[22:23], v[22:23], v[142:143]
    v_cvt_pk_bf16_f32 v150, v20, v21
    v_cvt_pk_bf16_f32 v151, v22, v23
    ds_write_b64 v127, v[150:151] offset:6144
    v_pk_fma_f32 v[24:25], v[24:25], v[128:129], v[132:133]
    v_pk_fma_f32 v[26:27], v[26:27], v[130:131], v[134:135]
    v_pk_fma_f32 v[28:29], v[28:29], v[128:129], v[132:133]
    v_pk_fma_f32 v[30:31], v[30:31], v[130:131], v[134:135]
    v_exp_f32 v136, v24
    v_exp_f32 v137, v25
    v_exp_f32 v138, v26
    v_exp_f32 v139, v27
    v_exp_f32 v140, v28
    v_exp_f32 v141, v29
    v_exp_f32 v142, v30
    v_exp_f32 v143, v31
    v_pk_fma_f32 v[136:137], v[136:137], s[6:7], s[6:7]
    s_waitcnt lgkmcnt(0)
    s_barrier
    v_pk_fma_f32 v[138:139], v[138:139], s[6:7], s[6:7]
    v_pk_fma_f32 v[140:141], v[140:141], s[6:7], s[6:7]
    v_pk_fma_f32 v[142:143], v[142:143], s[6:7], s[6:7]
    v_rcp_f32 v136, v136
    v_rcp_f32 v137, v137
    v_rcp_f32 v138, v138
    v_rcp_f32 v139, v139
    v_rcp_f32 v140, v140
    v_rcp_f32 v141, v141
    v_rcp_f32 v142, v142
    v_rcp_f32 v143, v143
    v_pk_mul_f32 v[24:25], v[24:25], v[136:137]
    v_pk_mul_f32 v[26:27], v[26:27], v[138:139]
    v_cvt_pk_bf16_f32 v144, v24, v25
    v_cvt_pk_bf16_f32 v145, v26, v27
    v_pk_mul_f32 v[28:29], v[28:29], v[140:141]
    ds_write_b64 v127, v[144:145] offset:8192
    v_pk_mul_f32 v[30:31], v[30:31], v[142:143]
    v_cvt_pk_bf16_f32 v146, v28, v29
    v_cvt_pk_bf16_f32 v147, v30, v31
    ds_write_b64 v127, v[146:147] offset:10240
    s_waitcnt lgkmcnt(0)
    s_barrier
L_end:
    s_endpgm
.section .rodata,"a"
.p2align 6
.amdhsa_kernel standalone__batchnorm__prompt_kernel
  .amdhsa_next_free_vgpr 152
  .amdhsa_next_free_sgpr 72
  .amdhsa_accum_offset 152
  .amdhsa_group_segment_fixed_size 0
  .amdhsa_kernarg_size 72
  .amdhsa_user_sgpr_count 2
  .amdhsa_user_sgpr_kernarg_segment_ptr 1
  .amdhsa_system_sgpr_workgroup_id_x 1
  .amdhsa_float_denorm_mode_32 3
.end_amdhsa_kernel
```
